```python
import torch

def _softmax(x, axis=-1):
    return torch.softmax(x, dim=axis)
def _gelu(x):
    return torch.nn.functional.gelu(x, approximate="tanh")
def _silu(x):
    return torch.nn.functional.silu(x)
def _sigmoid(x):
    return torch.sigmoid(x)
def _layernorm(x, axis=-1, eps=1e-5):
    m = x.mean(dim=axis, keepdim=True)
    v = x.var(dim=axis, keepdim=True, unbiased=False)
    return (x - m) / torch.sqrt(v + eps)
def _scatter_add(tgt, idx, src, axis=0):
    return tgt.clone().index_add_(axis, idx, src)
def _segment_sum(src, seg, n):
    out = torch.zeros((n,) + src.shape[1:], dtype=src.dtype)
    return out.index_add_(0, seg, src)
def _pad(x, pw):
    flat = tuple(v for pair in reversed(pw) for v in pair)
    return torch.nn.functional.pad(x, flat)

kernel_name = 'standalone__gqa_softmax__sampling'

def setup_inputs():

    _w = (lambda a: (lambda t: t.to(torch.bfloat16) if t.is_floating_point() else t)(torch.as_tensor(a)))
    B, Hq, Hkv, Sq, Sk, D = 8, 32, 8, 1, 4096, 128
    return {
        "q": _w((lambda *s: torch.randn(*s, dtype=torch.bfloat16) * 0.8)(B, Hq, Sq, D)),
        "k": _w((lambda *s: torch.randn(*s, dtype=torch.bfloat16) * 0.8)(B, Hkv, Sk, D)),
        "v": _w((lambda *s: torch.randn(*s, dtype=torch.bfloat16) * 0.05)(B, Hkv, Sk, D)),
    }

def reference(q, k, v):
    B, Hq, Sq, D = q.shape
    Hkv = k.shape[1]
    rep = Hq // Hkv
    k = (lambda x, n, axis: torch.repeat_interleave(x, n, dim=axis))(k, rep, axis=1)
    v = (lambda x, n, axis: torch.repeat_interleave(x, n, dim=axis))(v, rep, axis=1)
    scale = D ** -0.5
    scores = torch.einsum("bhqd,bhkd->bhqk", q, k) * scale
    p = _softmax(scores, axis=-1)
    return torch.einsum("bhqk,bhkd->bhqd", p, v)
```

```asm
; @launch grid=(256,1,1) block=(320,1,1) lds=86016
.amdgcn_target "amdgcn-amd-amdhsa--gfx950"
.text
.globl standalone__gqa_softmax__sampling_kernel
.p2align 8
.type standalone__gqa_softmax__sampling_kernel,@function
standalone__gqa_softmax__sampling_kernel:
    s_cmp_ge_u32 s2, 256
    s_cbranch_scc1 L_end
    s_load_dwordx2 s[16:17], s[0:1], 8
    s_load_dwordx2 s[24:25], s[0:1], 0
    s_load_dwordx2 s[20:21], s[0:1], 16
    v_lshrrev_b32 v10, 6, v0
    v_lshlrev_b32 v1, 4, v0
    v_readfirstlane_b32 s40, v10
    v_and_b32 v1, 0x3f0, v1
    s_and_b32 s3, s2, 7
    s_lshl_b32 s3, s3, 5
    s_lshr_b32 s41, s2, 3
    s_or_b32 s41, s41, s3
    s_cmp_eq_u32 s40, 4
    s_cbranch_scc1 L_manager
    v_lshlrev_b32 v12, 2, v0
    v_and_b32 v12, 0xc0, v12
    v_xor_b32 v14, v1, v12
    v_xor_b32 v15, 16, v14
    v_xor_b32 v16, 32, v14
    v_xor_b32 v17, 48, v14
    s_lshl_b32 s3, s41, 6
    s_add_u32 s3, s3, s40
    s_lshl_b32 s43, s3, 12
    s_mul_i32 s4, s40, 12288
    s_add_u32 s4, s4, 12288
    s_mov_b32 m0, s4
    s_mov_b32 s18, 0x4000000
    s_mov_b32 s19, 0x20000
    s_waitcnt lgkmcnt(0)
    buffer_load_dwordx4 v14, s[16:19], s43 offen offset:0 nt lds
    buffer_load_dwordx4 v15, s[16:19], s43 offen offset:1024 nt lds
    buffer_load_dwordx4 v16, s[16:19], s43 offen offset:2048 nt lds
    buffer_load_dwordx4 v17, s[16:19], s43 offen offset:3072 nt lds
    s_mov_b32 s44, s43
    s_add_u32 s5, s4, 4096
    s_add_u32 s6, s4, 8192
    s_mov_b32 m0, s5
    s_add_u32 s43, s43, 16384
    buffer_load_dwordx4 v14, s[16:19], s43 offen offset:0 nt lds
    s_lshl_b32 s45, s40, 11
    s_mov_b32 m0, s45
    s_mov_b32 s26, 0x10000
    s_mov_b32 s27, 0x20000
    s_lshr_b32 s3, s41, 2
    s_lshl_b32 s3, s3, 10
    buffer_load_dwordx4 v1, s[24:27], s3 offen lds
    s_mov_b32 m0, s5
    s_mov_b32 s22, 0x4000000
    s_mov_b32 s23, 0x20000
    s_mov_b32 s42, 0x3e0293ee
    v_bfe_u32 v10, v0, 4, 2
    v_and_b32 v11, 15, v0
    v_and_b32 v12, 3, v0
    v_bfe_u32 v2, v0, 2, 2
    v_xor_b32 v11, v11, v10
    v_lshlrev_b32 v11, 4, v11
    v_lshl_add_u32 v11, v12, 10, v11
    v_lshl_add_u32 v11, v2, 8, v11
    v_add_u32 v18, s4, v11
    v_xor_b32 v19, 64, v18
    v_xor_b32 v20, 128, v18
    v_xor_b32 v21, 192, v18
    v_lshlrev_b32 v10, 4, v10
    v_lshl_add_u32 v10, v2, 8, v10
    v_add_u32 v10, s45, v10
    v_lshlrev_b32 v12, 4, v12
    v_mov_b32 v32, 0xffff
    v_mov_b32 v33, 0
    v_lshlrev_b64 v[4:5], v12, v[32:33]
    s_getreg_b32 s8, hwreg(HW_REG_XCC_ID, 0, 1)
    s_cmp_eq_u32 s8, 0
    s_cselect_b64 vcc, -1, 0
    s_waitcnt vmcnt(5)
    buffer_load_dwordx4 v15, s[16:19], s43 offen offset:1024 nt lds
    s_waitcnt vmcnt(6)
    s_waitcnt vmcnt(5)
    buffer_load_dwordx4 v16, s[16:19], s43 offen offset:2048 nt lds
    s_waitcnt vmcnt(6)
    s_waitcnt vmcnt(5)
    buffer_load_dwordx4 v17, s[16:19], s43 offen offset:3072 nt lds
    s_waitcnt vmcnt(6)
    s_waitcnt vmcnt(5)
    s_mov_b32 m0, s6
    s_add_u32 s43, s43, 16384
    buffer_load_dwordx4 v14, s[16:19], s43 offen offset:0 nt lds
    s_waitcnt vmcnt(6)
    s_waitcnt vmcnt(5)
    buffer_load_dwordx4 v15, s[16:19], s43 offen offset:1024 nt lds
    ds_read_b128 v[56:59], v18 offset:0
    ds_read_b128 v[60:63], v19 offset:0
    ds_read_b128 v[64:67], v20 offset:0
    ds_read_b128 v[68:71], v21 offset:0
    s_waitcnt vmcnt(6) lgkmcnt(0)
    s_waitcnt vmcnt(4)
    buffer_load_dwordx4 v16, s[16:19], s43 offen offset:2048 nt lds
    s_waitcnt vmcnt(6)
    ds_read_b128 v[40:43], v10 offset:0
    ds_read_b128 v[44:47], v10 offset:64
    ds_read_b128 v[48:51], v10 offset:128
    ds_read_b128 v[52:55], v10 offset:192
    s_waitcnt lgkmcnt(0)
    v_mfma_f32_16x16x32_bf16 v[72:75], v[56:59], v[40:43], 0
    v_mfma_f32_16x16x32_bf16 v[72:75], v[60:63], v[44:47], v[72:75]
    v_mfma_f32_16x16x32_bf16 v[72:75], v[64:67], v[48:51], v[72:75]
    v_mfma_f32_16x16x32_bf16 v[72:75], v[68:71], v[52:55], v[72:75]
    s_waitcnt vmcnt(5)
    s_waitcnt vmcnt(4)
    buffer_load_dwordx4 v17, s[16:19], s43 offen offset:3072 nt lds
    s_waitcnt vmcnt(5)
    s_waitcnt vmcnt(4)
    s_mov_b32 m0, s4
    s_add_u32 s43, s43, 16384
    buffer_load_dwordx4 v14, s[16:19], s43 offen offset:0 nt lds
    s_waitcnt vmcnt(5)
    s_waitcnt vmcnt(4)
    buffer_load_dwordx4 v15, s[16:19], s43 offen offset:1024 nt lds
    ds_read_b128 v[56:59], v18 offset:4096
    ds_read_b128 v[60:63], v19 offset:4096
    ds_read_b128 v[64:67], v20 offset:4096
    ds_read_b128 v[68:71], v21 offset:4096
    s_waitcnt vmcnt(5) lgkmcnt(0)
    s_waitcnt vmcnt(4)
    buffer_load_dwordx4 v16, s[16:19], s43 offen offset:2048 nt lds
    v_max3_f32 v7, v72, v73, v74
    v_max_f32 v7, v7, v75
    v_mfma_f32_16x16x32_bf16 v[76:79], v[56:59], v[40:43], 0
    v_mfma_f32_16x16x32_bf16 v[76:79], v[60:63], v[44:47], v[76:79]
    v_mfma_f32_16x16x32_bf16 v[76:79], v[64:67], v[48:51], v[76:79]
    v_mfma_f32_16x16x32_bf16 v[76:79], v[68:71], v[52:55], v[76:79]
    s_waitcnt vmcnt(5)
    s_waitcnt vmcnt(4)
    buffer_load_dwordx4 v17, s[16:19], s43 offen offset:3072 nt lds
    s_waitcnt vmcnt(5)
    s_waitcnt vmcnt(4)
    s_mov_b32 m0, s5
    s_add_u32 s43, s43, 16384
    buffer_load_dwordx4 v14, s[16:19], s43 offen offset:0 nt lds
    s_waitcnt vmcnt(5)
    s_waitcnt vmcnt(4)
    buffer_load_dwordx4 v15, s[16:19], s43 offen offset:1024 nt lds
    ds_read_b128 v[56:59], v18 offset:8192
    ds_read_b128 v[60:63], v19 offset:8192
    ds_read_b128 v[64:67], v20 offset:8192
    ds_read_b128 v[68:71], v21 offset:8192
    s_waitcnt vmcnt(5) lgkmcnt(0)
    s_waitcnt vmcnt(4)
    buffer_load_dwordx4 v16, s[16:19], s43 offen offset:2048 nt lds
    v_max3_f32 v7, v7, v76, v77
    v_max3_f32 v7, v7, v78, v79
    v_mfma_f32_16x16x32_bf16 v[80:83], v[56:59], v[40:43], 0
    v_mfma_f32_16x16x32_bf16 v[80:83], v[60:63], v[44:47], v[80:83]
    v_mfma_f32_16x16x32_bf16 v[80:83], v[64:67], v[48:51], v[80:83]
    v_mfma_f32_16x16x32_bf16 v[80:83], v[68:71], v[52:55], v[80:83]
    s_waitcnt vmcnt(5)
    s_waitcnt vmcnt(4)
    buffer_load_dwordx4 v17, s[16:19], s43 offen offset:3072 nt lds
    s_waitcnt vmcnt(5)
    s_waitcnt vmcnt(4)
    s_mov_b32 m0, s6
    s_add_u32 s43, s43, 16384
    buffer_load_dwordx4 v14, s[16:19], s43 offen offset:0 nt lds
    s_waitcnt vmcnt(5)
    s_waitcnt vmcnt(4)
    buffer_load_dwordx4 v15, s[16:19], s43 offen offset:1024 nt lds
    ds_read_b128 v[56:59], v18 offset:0
    ds_read_b128 v[60:63], v19 offset:0
    ds_read_b128 v[64:67], v20 offset:0
    ds_read_b128 v[68:71], v21 offset:0
    s_waitcnt vmcnt(5) lgkmcnt(0)
    s_waitcnt vmcnt(4)
    buffer_load_dwordx4 v16, s[16:19], s43 offen offset:2048 nt lds
    v_max3_f32 v7, v7, v80, v81
    v_max3_f32 v7, v7, v82, v83
    v_mfma_f32_16x16x32_bf16 v[84:87], v[56:59], v[40:43], 0
    v_mfma_f32_16x16x32_bf16 v[84:87], v[60:63], v[44:47], v[84:87]
    v_mfma_f32_16x16x32_bf16 v[84:87], v[64:67], v[48:51], v[84:87]
    v_mfma_f32_16x16x32_bf16 v[84:87], v[68:71], v[52:55], v[84:87]
    s_waitcnt vmcnt(5)
    s_waitcnt vmcnt(4)
    buffer_load_dwordx4 v17, s[16:19], s43 offen offset:3072 nt lds
    s_waitcnt vmcnt(5)
    s_waitcnt vmcnt(4)
    s_mov_b32 m0, s4
    s_add_u32 s43, s43, 16384
    buffer_load_dwordx4 v14, s[16:19], s43 offen offset:0 nt lds
    s_waitcnt vmcnt(5)
    s_waitcnt vmcnt(4)
    buffer_load_dwordx4 v15, s[16:19], s43 offen offset:1024 nt lds
    ds_read_b128 v[56:59], v18 offset:4096
    ds_read_b128 v[60:63], v19 offset:4096
    ds_read_b128 v[64:67], v20 offset:4096
    ds_read_b128 v[68:71], v21 offset:4096
    s_waitcnt vmcnt(5) lgkmcnt(0)
    s_waitcnt vmcnt(4)
    buffer_load_dwordx4 v16, s[16:19], s43 offen offset:2048 nt lds
    v_max3_f32 v7, v7, v84, v85
    v_max3_f32 v7, v7, v86, v87
    v_mfma_f32_16x16x32_bf16 v[88:91], v[56:59], v[40:43], 0
    v_mfma_f32_16x16x32_bf16 v[88:91], v[60:63], v[44:47], v[88:91]
    v_mfma_f32_16x16x32_bf16 v[88:91], v[64:67], v[48:51], v[88:91]
    v_mfma_f32_16x16x32_bf16 v[88:91], v[68:71], v[52:55], v[88:91]
    s_waitcnt vmcnt(5)
    s_waitcnt vmcnt(4)
    buffer_load_dwordx4 v17, s[16:19], s43 offen offset:3072 nt lds
    s_waitcnt vmcnt(5)
    s_waitcnt vmcnt(4)
    s_mov_b32 m0, s5
    s_add_u32 s43, s43, 16384
    buffer_load_dwordx4 v14, s[16:19], s43 offen offset:0 nt lds
    s_waitcnt vmcnt(5)
    s_waitcnt vmcnt(4)
    buffer_load_dwordx4 v15, s[16:19], s43 offen offset:1024 nt lds
    ds_read_b128 v[56:59], v18 offset:8192
    ds_read_b128 v[60:63], v19 offset:8192
    ds_read_b128 v[64:67], v20 offset:8192
    ds_read_b128 v[68:71], v21 offset:8192
    s_waitcnt vmcnt(5) lgkmcnt(0)
    s_waitcnt vmcnt(4)
    buffer_load_dwordx4 v16, s[16:19], s43 offen offset:2048 nt lds
    v_max3_f32 v7, v7, v88, v89
    v_max3_f32 v7, v7, v90, v91
    v_mfma_f32_16x16x32_bf16 v[92:95], v[56:59], v[40:43], 0
    v_mfma_f32_16x16x32_bf16 v[92:95], v[60:63], v[44:47], v[92:95]
    v_mfma_f32_16x16x32_bf16 v[92:95], v[64:67], v[48:51], v[92:95]
    v_mfma_f32_16x16x32_bf16 v[92:95], v[68:71], v[52:55], v[92:95]
    s_waitcnt vmcnt(5)
    s_waitcnt vmcnt(4)
    buffer_load_dwordx4 v17, s[16:19], s43 offen offset:3072 nt lds
    s_waitcnt vmcnt(5)
    s_waitcnt vmcnt(4)
    s_mov_b32 m0, s6
    s_add_u32 s43, s43, 16384
    buffer_load_dwordx4 v14, s[16:19], s43 offen offset:0 nt lds
    s_waitcnt vmcnt(5)
    s_waitcnt vmcnt(4)
    buffer_load_dwordx4 v15, s[16:19], s43 offen offset:1024 nt lds
    ds_read_b128 v[56:59], v18 offset:0
    ds_read_b128 v[60:63], v19 offset:0
    ds_read_b128 v[64:67], v20 offset:0
    ds_read_b128 v[68:71], v21 offset:0
    s_waitcnt vmcnt(5) lgkmcnt(0)
    s_waitcnt vmcnt(4)
    buffer_load_dwordx4 v16, s[16:19], s43 offen offset:2048 nt lds
    v_max3_f32 v7, v7, v92, v93
    v_max3_f32 v7, v7, v94, v95
    v_mfma_f32_16x16x32_bf16 v[96:99], v[56:59], v[40:43], 0
    v_mfma_f32_16x16x32_bf16 v[96:99], v[60:63], v[44:47], v[96:99]
    v_mfma_f32_16x16x32_bf16 v[96:99], v[64:67], v[48:51], v[96:99]
    v_mfma_f32_16x16x32_bf16 v[96:99], v[68:71], v[52:55], v[96:99]
    s_waitcnt vmcnt(5)
    s_waitcnt vmcnt(4)
    buffer_load_dwordx4 v17, s[16:19], s43 offen offset:3072 nt lds
    s_waitcnt vmcnt(5)
    s_waitcnt vmcnt(4)
    s_mov_b32 m0, s4
    s_add_u32 s43, s43, 16384
    buffer_load_dwordx4 v14, s[16:19], s43 offen offset:0 nt lds
    s_waitcnt vmcnt(5)
    s_waitcnt vmcnt(4)
    buffer_load_dwordx4 v15, s[16:19], s43 offen offset:1024 nt lds
    ds_read_b128 v[56:59], v18 offset:4096
    ds_read_b128 v[60:63], v19 offset:4096
    ds_read_b128 v[64:67], v20 offset:4096
    ds_read_b128 v[68:71], v21 offset:4096
    s_waitcnt vmcnt(5) lgkmcnt(0)
    s_waitcnt vmcnt(4)
    buffer_load_dwordx4 v16, s[16:19], s43 offen offset:2048 nt lds
    v_max3_f32 v7, v7, v96, v97
    v_max3_f32 v7, v7, v98, v99
    v_mfma_f32_16x16x32_bf16 v[100:103], v[56:59], v[40:43], 0
    v_mfma_f32_16x16x32_bf16 v[100:103], v[60:63], v[44:47], v[100:103]
    v_mfma_f32_16x16x32_bf16 v[100:103], v[64:67], v[48:51], v[100:103]
    v_mfma_f32_16x16x32_bf16 v[100:103], v[68:71], v[52:55], v[100:103]
    s_waitcnt vmcnt(5)
    s_waitcnt vmcnt(4)
    buffer_load_dwordx4 v17, s[16:19], s43 offen offset:3072 nt lds
    s_waitcnt vmcnt(5)
    s_waitcnt vmcnt(4)
    s_mov_b32 m0, s5
    s_add_u32 s43, s43, 16384
    buffer_load_dwordx4 v14, s[16:19], s43 offen offset:0 nt lds
    s_waitcnt vmcnt(5)
    s_waitcnt vmcnt(4)
    buffer_load_dwordx4 v15, s[16:19], s43 offen offset:1024 nt lds
    ds_read_b128 v[56:59], v18 offset:8192
    ds_read_b128 v[60:63], v19 offset:8192
    ds_read_b128 v[64:67], v20 offset:8192
    ds_read_b128 v[68:71], v21 offset:8192
    s_waitcnt vmcnt(5) lgkmcnt(0)
    s_waitcnt vmcnt(4)
    buffer_load_dwordx4 v16, s[16:19], s43 offen offset:2048 nt lds
    v_max3_f32 v7, v7, v100, v101
    v_max3_f32 v7, v7, v102, v103
    v_mfma_f32_16x16x32_bf16 v[104:107], v[56:59], v[40:43], 0
    v_mfma_f32_16x16x32_bf16 v[104:107], v[60:63], v[44:47], v[104:107]
    v_mfma_f32_16x16x32_bf16 v[104:107], v[64:67], v[48:51], v[104:107]
    v_mfma_f32_16x16x32_bf16 v[104:107], v[68:71], v[52:55], v[104:107]
    s_waitcnt vmcnt(5)
    s_waitcnt vmcnt(4)
    buffer_load_dwordx4 v17, s[16:19], s43 offen offset:3072 nt lds
    s_waitcnt vmcnt(5)
    s_waitcnt vmcnt(4)
    s_mov_b32 m0, s6
    s_add_u32 s43, s43, 16384
    buffer_load_dwordx4 v14, s[16:19], s43 offen offset:0 nt lds
    s_waitcnt vmcnt(5)
    s_waitcnt vmcnt(4)
    buffer_load_dwordx4 v15, s[16:19], s43 offen offset:1024 nt lds
    ds_read_b128 v[56:59], v18 offset:0
    ds_read_b128 v[60:63], v19 offset:0
    ds_read_b128 v[64:67], v20 offset:0
    ds_read_b128 v[68:71], v21 offset:0
    s_waitcnt vmcnt(5) lgkmcnt(0)
    s_waitcnt vmcnt(4)
    buffer_load_dwordx4 v16, s[16:19], s43 offen offset:2048 nt lds
    v_max3_f32 v7, v7, v104, v105
    v_max3_f32 v7, v7, v106, v107
    v_mfma_f32_16x16x32_bf16 v[108:111], v[56:59], v[40:43], 0
    v_mfma_f32_16x16x32_bf16 v[108:111], v[60:63], v[44:47], v[108:111]
    v_mfma_f32_16x16x32_bf16 v[108:111], v[64:67], v[48:51], v[108:111]
    v_mfma_f32_16x16x32_bf16 v[108:111], v[68:71], v[52:55], v[108:111]
    s_waitcnt vmcnt(5)
    s_waitcnt vmcnt(4)
    buffer_load_dwordx4 v17, s[16:19], s43 offen offset:3072 nt lds
    s_waitcnt vmcnt(5)
    s_waitcnt vmcnt(4)
    s_mov_b32 m0, s4
    s_add_u32 s43, s43, 16384
    buffer_load_dwordx4 v14, s[16:19], s43 offen offset:0 nt lds
    s_waitcnt vmcnt(5)
    s_waitcnt vmcnt(4)
    buffer_load_dwordx4 v15, s[16:19], s43 offen offset:1024 nt lds
    ds_read_b128 v[56:59], v18 offset:4096
    ds_read_b128 v[60:63], v19 offset:4096
    ds_read_b128 v[64:67], v20 offset:4096
    ds_read_b128 v[68:71], v21 offset:4096
    s_waitcnt vmcnt(5) lgkmcnt(0)
    s_waitcnt vmcnt(4)
    buffer_load_dwordx4 v16, s[16:19], s43 offen offset:2048 nt lds
    v_max3_f32 v7, v7, v108, v109
    v_max3_f32 v7, v7, v110, v111
    v_mfma_f32_16x16x32_bf16 v[112:115], v[56:59], v[40:43], 0
    v_mfma_f32_16x16x32_bf16 v[112:115], v[60:63], v[44:47], v[112:115]
    v_mfma_f32_16x16x32_bf16 v[112:115], v[64:67], v[48:51], v[112:115]
    v_mfma_f32_16x16x32_bf16 v[112:115], v[68:71], v[52:55], v[112:115]
    s_waitcnt vmcnt(5)
    s_waitcnt vmcnt(4)
    buffer_load_dwordx4 v17, s[16:19], s43 offen offset:3072 nt lds
    s_waitcnt vmcnt(5)
    s_cbranch_vccnz T_52
    s_waitcnt vmcnt(4)
T_52:
    s_mov_b32 m0, s5
    s_add_u32 s43, s43, 16384
    buffer_load_dwordx4 v14, s[16:19], s43 offen offset:0 nt lds
    s_waitcnt vmcnt(5)
    s_cbranch_vccnz T_53
    s_waitcnt vmcnt(4)
T_53:
    buffer_load_dwordx4 v15, s[16:19], s43 offen offset:1024 nt lds
    ds_read_b128 v[56:59], v18 offset:8192
    ds_read_b128 v[60:63], v19 offset:8192
    ds_read_b128 v[64:67], v20 offset:8192
    ds_read_b128 v[68:71], v21 offset:8192
    s_waitcnt vmcnt(5) lgkmcnt(0)
    s_cbranch_vccnz T_54
    s_waitcnt vmcnt(4)
T_54:
    buffer_load_dwordx4 v16, s[16:19], s43 offen offset:2048 nt lds
    v_max3_f32 v7, v7, v112, v113
    v_max3_f32 v7, v7, v114, v115
    v_mfma_f32_16x16x32_bf16 v[116:119], v[56:59], v[40:43], 0
    v_mfma_f32_16x16x32_bf16 v[116:119], v[60:63], v[44:47], v[116:119]
    v_mfma_f32_16x16x32_bf16 v[116:119], v[64:67], v[48:51], v[116:119]
    v_mfma_f32_16x16x32_bf16 v[116:119], v[68:71], v[52:55], v[116:119]
    s_waitcnt vmcnt(5)
    s_cbranch_vccnz T_55
    s_waitcnt vmcnt(4)
T_55:
    buffer_load_dwordx4 v17, s[16:19], s43 offen offset:3072 nt lds
    s_waitcnt vmcnt(5)
    s_cbranch_vccnz T_56
    s_waitcnt vmcnt(4)
T_56:
    s_mov_b32 m0, s6
    s_add_u32 s43, s43, 16384
    buffer_load_dwordx4 v14, s[16:19], s43 offen offset:0 nt lds
    s_waitcnt vmcnt(5)
    s_cbranch_vccnz T_57
    s_waitcnt vmcnt(4)
T_57:
    buffer_load_dwordx4 v15, s[16:19], s43 offen offset:1024 nt lds
    ds_read_b128 v[56:59], v18 offset:0
    ds_read_b128 v[60:63], v19 offset:0
    ds_read_b128 v[64:67], v20 offset:0
    ds_read_b128 v[68:71], v21 offset:0
    s_waitcnt vmcnt(5) lgkmcnt(0)
    s_cbranch_vccnz T_58
    s_waitcnt vmcnt(4)
T_58:
    buffer_load_dwordx4 v16, s[16:19], s43 offen offset:2048 nt lds
    v_max3_f32 v7, v7, v116, v117
    v_max3_f32 v7, v7, v118, v119
    v_mfma_f32_16x16x32_bf16 v[120:123], v[56:59], v[40:43], 0
    v_mfma_f32_16x16x32_bf16 v[120:123], v[60:63], v[44:47], v[120:123]
    v_mfma_f32_16x16x32_bf16 v[120:123], v[64:67], v[48:51], v[120:123]
    v_mfma_f32_16x16x32_bf16 v[120:123], v[68:71], v[52:55], v[120:123]
    s_waitcnt vmcnt(5)
    s_cbranch_vccnz T_59
    s_waitcnt vmcnt(4)
T_59:
    buffer_load_dwordx4 v17, s[16:19], s43 offen offset:3072 nt lds
    s_waitcnt vmcnt(5)
    s_cbranch_vccnz T_60
    s_waitcnt vmcnt(4)
T_60:
    s_mov_b32 m0, s4
    s_add_u32 s43, s43, 16384
    buffer_load_dwordx4 v14, s[16:19], s43 offen offset:0 nt lds
    s_waitcnt vmcnt(5)
    s_cbranch_vccnz T_61
    s_waitcnt vmcnt(4)
T_61:
    buffer_load_dwordx4 v15, s[16:19], s43 offen offset:1024 nt lds
    ds_read_b128 v[56:59], v18 offset:4096
    ds_read_b128 v[60:63], v19 offset:4096
    ds_read_b128 v[64:67], v20 offset:4096
    ds_read_b128 v[68:71], v21 offset:4096
    s_waitcnt vmcnt(5) lgkmcnt(0)
    s_cbranch_vccnz T_62
    s_waitcnt vmcnt(4)
T_62:
    buffer_load_dwordx4 v16, s[16:19], s43 offen offset:2048 nt lds
    v_max3_f32 v7, v7, v120, v121
    v_max3_f32 v7, v7, v122, v123
    v_mfma_f32_16x16x32_bf16 v[124:127], v[56:59], v[40:43], 0
    v_mfma_f32_16x16x32_bf16 v[124:127], v[60:63], v[44:47], v[124:127]
    v_mfma_f32_16x16x32_bf16 v[124:127], v[64:67], v[48:51], v[124:127]
    v_mfma_f32_16x16x32_bf16 v[124:127], v[68:71], v[52:55], v[124:127]
    s_waitcnt vmcnt(5)
    s_cbranch_vccnz T_63
    s_waitcnt vmcnt(4)
T_63:
    buffer_load_dwordx4 v17, s[16:19], s43 offen offset:3072 nt lds
    s_waitcnt vmcnt(5)
    s_cbranch_vccnz T_64
    s_waitcnt vmcnt(4)
T_64:
    buffer_load_dwordx4 v[136:139], v1, s[20:23], s44 offen offset:0 nt
    s_waitcnt vmcnt(5)
    s_cbranch_vccnz T_65
    s_waitcnt vmcnt(4)
T_65:
    buffer_load_dwordx4 v[140:143], v1, s[20:23], s44 offen offset:1024 nt
    ds_read_b128 v[56:59], v18 offset:8192
    ds_read_b128 v[60:63], v19 offset:8192
    ds_read_b128 v[64:67], v20 offset:8192
    ds_read_b128 v[68:71], v21 offset:8192
    s_waitcnt vmcnt(5) lgkmcnt(0)
    s_cbranch_vccnz T_66
    s_waitcnt vmcnt(4)
T_66:
    buffer_load_dwordx4 v[144:147], v1, s[20:23], s44 offen offset:2048 nt
    v_max3_f32 v7, v7, v124, v125
    v_max3_f32 v7, v7, v126, v127
    v_mfma_f32_16x16x32_bf16 v[128:131], v[56:59], v[40:43], 0
    v_mfma_f32_16x16x32_bf16 v[128:131], v[60:63], v[44:47], v[128:131]
    v_mfma_f32_16x16x32_bf16 v[128:131], v[64:67], v[48:51], v[128:131]
    v_mfma_f32_16x16x32_bf16 v[128:131], v[68:71], v[52:55], v[128:131]
    s_waitcnt vmcnt(5)
    s_cbranch_vccnz T_67
    s_waitcnt vmcnt(4)
T_67:
    buffer_load_dwordx4 v[148:151], v1, s[20:23], s44 offen offset:3072 nt
    s_waitcnt vmcnt(5)
    s_cbranch_vccnz T_68
    s_waitcnt vmcnt(4)
T_68:
    s_add_u32 s44, s44, 16384
    buffer_load_dwordx4 v[152:155], v1, s[20:23], s44 offen offset:0 nt
    s_waitcnt vmcnt(5)
    s_cbranch_vccnz T_69
    s_waitcnt vmcnt(4)
T_69:
    buffer_load_dwordx4 v[156:159], v1, s[20:23], s44 offen offset:1024 nt
    ds_read_b128 v[56:59], v18 offset:0
    ds_read_b128 v[60:63], v19 offset:0
    ds_read_b128 v[64:67], v20 offset:0
    ds_read_b128 v[68:71], v21 offset:0
    v_max3_f32 v7, v7, v128, v129
    v_max3_f32 v7, v7, v130, v131
    s_waitcnt lgkmcnt(0)
    v_mfma_f32_16x16x32_bf16 v[132:135], v[56:59], v[40:43], 0
    v_mfma_f32_16x16x32_bf16 v[132:135], v[60:63], v[44:47], v[132:135]
    v_mfma_f32_16x16x32_bf16 v[132:135], v[64:67], v[48:51], v[132:135]
    v_mfma_f32_16x16x32_bf16 v[132:135], v[68:71], v[52:55], v[132:135]
    s_lshl_b32 s3, s40, 2
    v_lshlrev_b32 v2, 4, v2
    v_add_u32 v2, s3, v2
    s_nop 4
    v_max3_f32 v7, v7, v132, v133
    v_max3_f32 v7, v7, v134, v135
    v_mov_b32 v11, v7
    s_nop 1
    v_permlane32_swap_b32 v11, v7
    v_max_f32 v7, v7, v11
    v_mov_b32 v11, v7
    s_nop 1
    v_permlane16_swap_b32 v11, v7
    v_max_f32 v7, v7, v11
    v_mul_f32 v7, s42, v7
    ds_write_b32 v2, v7 offset:8192
    v_fma_f32 v72, v72, s42, -v7
    v_fma_f32 v73, v73, s42, -v7
    v_fma_f32 v74, v74, s42, -v7
    v_fma_f32 v75, v75, s42, -v7
    v_exp_f32 v72, v72
    v_exp_f32 v73, v73
    v_exp_f32 v74, v74
    v_exp_f32 v75, v75
    s_nop 0
    v_add_f32 v9, v72, v73
    v_add_f32 v9, v9, v74
    v_add_f32 v9, v9, v75
    v_cvt_pk_bf16_f32 v33, v72, v72
    v_cvt_pk_bf16_f32 v35, v73, v73
    v_cvt_pk_bf16_f32 v37, v74, v74
    v_cvt_pk_bf16_f32 v39, v75, v75
    v_and_b32 v32, v4, v33
    v_and_b32 v33, v5, v33
    v_and_b32 v34, v4, v35
    v_and_b32 v35, v5, v35
    v_and_b32 v36, v4, v37
    v_and_b32 v37, v5, v37
    v_and_b32 v38, v4, v39
    v_and_b32 v39, v5, v39
    s_nop 0
    s_waitcnt vmcnt(5)
    v_mfma_f32_16x16x16_bf16 v[24:27], v[32:33], v[136:137], 0
    v_mfma_f32_16x16x16_bf16 v[28:31], v[32:33], v[138:139], 0
    buffer_load_dwordx4 v[160:163], v1, s[20:23], s44 offen offset:2048 nt
    s_waitcnt vmcnt(5)
    v_mfma_f32_16x16x16_bf16 v[24:27], v[34:35], v[140:141], v[24:27]
    v_mfma_f32_16x16x16_bf16 v[28:31], v[34:35], v[142:143], v[28:31]
    buffer_load_dwordx4 v[164:167], v1, s[20:23], s44 offen offset:3072 nt
    s_waitcnt vmcnt(5)
    v_mfma_f32_16x16x16_bf16 v[24:27], v[36:37], v[144:145], v[24:27]
    v_mfma_f32_16x16x16_bf16 v[28:31], v[36:37], v[146:147], v[28:31]
    s_add_u32 s44, s44, 16384
    buffer_load_dwordx4 v[168:171], v1, s[20:23], s44 offen offset:0 nt
    s_waitcnt vmcnt(5)
    v_mfma_f32_16x16x16_bf16 v[24:27], v[38:39], v[148:149], v[24:27]
    v_mfma_f32_16x16x16_bf16 v[28:31], v[38:39], v[150:151], v[28:31]
    buffer_load_dwordx4 v[172:175], v1, s[20:23], s44 offen offset:1024 nt
    v_fma_f32 v76, v76, s42, -v7
    v_fma_f32 v77, v77, s42, -v7
    v_fma_f32 v78, v78, s42, -v7
    v_fma_f32 v79, v79, s42, -v7
    v_exp_f32 v76, v76
    v_exp_f32 v77, v77
    v_exp_f32 v78, v78
    v_exp_f32 v79, v79
    s_nop 0
    v_add_f32 v9, v9, v76
    v_add_f32 v9, v9, v77
    v_add_f32 v9, v9, v78
    v_add_f32 v9, v9, v79
    v_fma_f32 v80, v80, s42, -v7
    v_fma_f32 v81, v81, s42, -v7
    v_fma_f32 v82, v82, s42, -v7
    v_fma_f32 v83, v83, s42, -v7
    v_exp_f32 v80, v80
    v_exp_f32 v81, v81
    v_exp_f32 v82, v82
    v_exp_f32 v83, v83
    s_nop 0
    v_add_f32 v9, v9, v80
    v_add_f32 v9, v9, v81
    v_add_f32 v9, v9, v82
    v_add_f32 v9, v9, v83
    v_cvt_pk_bf16_f32 v33, v76, v76
    v_cvt_pk_bf16_f32 v35, v77, v77
    v_cvt_pk_bf16_f32 v37, v78, v78
    v_cvt_pk_bf16_f32 v39, v79, v79
    v_and_b32 v32, v4, v33
    v_and_b32 v33, v5, v33
    v_and_b32 v34, v4, v35
    v_and_b32 v35, v5, v35
    v_and_b32 v36, v4, v37
    v_and_b32 v37, v5, v37
    v_and_b32 v38, v4, v39
    v_and_b32 v39, v5, v39
    s_nop 0
    s_waitcnt vmcnt(5)
    v_mfma_f32_16x16x16_bf16 v[24:27], v[32:33], v[152:153], v[24:27]
    v_mfma_f32_16x16x16_bf16 v[28:31], v[32:33], v[154:155], v[28:31]
    buffer_load_dwordx4 v[176:179], v1, s[20:23], s44 offen offset:2048 nt
    s_waitcnt vmcnt(5)
    v_mfma_f32_16x16x16_bf16 v[24:27], v[34:35], v[156:157], v[24:27]
    v_mfma_f32_16x16x16_bf16 v[28:31], v[34:35], v[158:159], v[28:31]
    buffer_load_dwordx4 v[180:183], v1, s[20:23], s44 offen offset:3072 nt
    s_waitcnt vmcnt(5)
    v_mfma_f32_16x16x16_bf16 v[24:27], v[36:37], v[160:161], v[24:27]
    v_mfma_f32_16x16x16_bf16 v[28:31], v[36:37], v[162:163], v[28:31]
    s_add_u32 s44, s44, 16384
    buffer_load_dwordx4 v[136:139], v1, s[20:23], s44 offen offset:0 nt
    s_waitcnt vmcnt(5)
    v_mfma_f32_16x16x16_bf16 v[24:27], v[38:39], v[164:165], v[24:27]
    v_mfma_f32_16x16x16_bf16 v[28:31], v[38:39], v[166:167], v[28:31]
    buffer_load_dwordx4 v[140:143], v1, s[20:23], s44 offen offset:1024 nt
    v_fma_f32 v84, v84, s42, -v7
    v_fma_f32 v85, v85, s42, -v7
    v_fma_f32 v86, v86, s42, -v7
    v_fma_f32 v87, v87, s42, -v7
    v_exp_f32 v84, v84
    v_exp_f32 v85, v85
    v_exp_f32 v86, v86
    v_exp_f32 v87, v87
    s_nop 0
    v_add_f32 v9, v9, v84
    v_add_f32 v9, v9, v85
    v_add_f32 v9, v9, v86
    v_add_f32 v9, v9, v87
    v_fma_f32 v88, v88, s42, -v7
    v_fma_f32 v89, v89, s42, -v7
    v_fma_f32 v90, v90, s42, -v7
    v_fma_f32 v91, v91, s42, -v7
    v_exp_f32 v88, v88
    v_exp_f32 v89, v89
    v_exp_f32 v90, v90
    v_exp_f32 v91, v91
    s_nop 0
    v_add_f32 v9, v9, v88
    v_add_f32 v9, v9, v89
    v_add_f32 v9, v9, v90
    v_add_f32 v9, v9, v91
    v_cvt_pk_bf16_f32 v33, v80, v80
    v_cvt_pk_bf16_f32 v35, v81, v81
    v_cvt_pk_bf16_f32 v37, v82, v82
    v_cvt_pk_bf16_f32 v39, v83, v83
    v_and_b32 v32, v4, v33
    v_and_b32 v33, v5, v33
    v_and_b32 v34, v4, v35
    v_and_b32 v35, v5, v35
    v_and_b32 v36, v4, v37
    v_and_b32 v37, v5, v37
    v_and_b32 v38, v4, v39
    v_and_b32 v39, v5, v39
    s_nop 0
    s_waitcnt vmcnt(5)
    v_mfma_f32_16x16x16_bf16 v[24:27], v[32:33], v[168:169], v[24:27]
    v_mfma_f32_16x16x16_bf16 v[28:31], v[32:33], v[170:171], v[28:31]
    buffer_load_dwordx4 v[144:147], v1, s[20:23], s44 offen offset:2048 nt
    s_waitcnt vmcnt(5)
    v_mfma_f32_16x16x16_bf16 v[24:27], v[34:35], v[172:173], v[24:27]
    v_mfma_f32_16x16x16_bf16 v[28:31], v[34:35], v[174:175], v[28:31]
    buffer_load_dwordx4 v[148:151], v1, s[20:23], s44 offen offset:3072 nt
    s_waitcnt vmcnt(5)
    v_mfma_f32_16x16x16_bf16 v[24:27], v[36:37], v[176:177], v[24:27]
    v_mfma_f32_16x16x16_bf16 v[28:31], v[36:37], v[178:179], v[28:31]
    s_add_u32 s44, s44, 16384
    buffer_load_dwordx4 v[152:155], v1, s[20:23], s44 offen offset:0 nt
    s_waitcnt vmcnt(5)
    v_mfma_f32_16x16x16_bf16 v[24:27], v[38:39], v[180:181], v[24:27]
    v_mfma_f32_16x16x16_bf16 v[28:31], v[38:39], v[182:183], v[28:31]
    buffer_load_dwordx4 v[156:159], v1, s[20:23], s44 offen offset:1024 nt
    v_fma_f32 v92, v92, s42, -v7
    v_fma_f32 v93, v93, s42, -v7
    v_fma_f32 v94, v94, s42, -v7
    v_fma_f32 v95, v95, s42, -v7
    v_exp_f32 v92, v92
    v_exp_f32 v93, v93
    v_exp_f32 v94, v94
    v_exp_f32 v95, v95
    s_nop 0
    v_add_f32 v9, v9, v92
    v_add_f32 v9, v9, v93
    v_add_f32 v9, v9, v94
    v_add_f32 v9, v9, v95
    v_cvt_pk_bf16_f32 v33, v84, v84
    v_cvt_pk_bf16_f32 v35, v85, v85
    v_cvt_pk_bf16_f32 v37, v86, v86
    v_cvt_pk_bf16_f32 v39, v87, v87
    v_and_b32 v32, v4, v33
    v_and_b32 v33, v5, v33
    v_and_b32 v34, v4, v35
    v_and_b32 v35, v5, v35
    v_and_b32 v36, v4, v37
    v_and_b32 v37, v5, v37
    v_and_b32 v38, v4, v39
    v_and_b32 v39, v5, v39
    s_nop 0
    s_waitcnt vmcnt(5)
    v_mfma_f32_16x16x16_bf16 v[24:27], v[32:33], v[136:137], v[24:27]
    v_mfma_f32_16x16x16_bf16 v[28:31], v[32:33], v[138:139], v[28:31]
    buffer_load_dwordx4 v[160:163], v1, s[20:23], s44 offen offset:2048 nt
    s_waitcnt vmcnt(5)
    v_mfma_f32_16x16x16_bf16 v[24:27], v[34:35], v[140:141], v[24:27]
    v_mfma_f32_16x16x16_bf16 v[28:31], v[34:35], v[142:143], v[28:31]
    buffer_load_dwordx4 v[164:167], v1, s[20:23], s44 offen offset:3072 nt
    s_waitcnt vmcnt(5)
    v_mfma_f32_16x16x16_bf16 v[24:27], v[36:37], v[144:145], v[24:27]
    v_mfma_f32_16x16x16_bf16 v[28:31], v[36:37], v[146:147], v[28:31]
    s_add_u32 s44, s44, 16384
    buffer_load_dwordx4 v[168:171], v1, s[20:23], s44 offen offset:0 nt
    s_waitcnt vmcnt(5)
    v_mfma_f32_16x16x16_bf16 v[24:27], v[38:39], v[148:149], v[24:27]
    v_mfma_f32_16x16x16_bf16 v[28:31], v[38:39], v[150:151], v[28:31]
    buffer_load_dwordx4 v[172:175], v1, s[20:23], s44 offen offset:1024 nt
    v_fma_f32 v96, v96, s42, -v7
    v_fma_f32 v97, v97, s42, -v7
    v_fma_f32 v98, v98, s42, -v7
    v_fma_f32 v99, v99, s42, -v7
    v_exp_f32 v96, v96
    v_exp_f32 v97, v97
    v_exp_f32 v98, v98
    v_exp_f32 v99, v99
    s_nop 0
    v_add_f32 v9, v9, v96
    v_add_f32 v9, v9, v97
    v_add_f32 v9, v9, v98
    v_add_f32 v9, v9, v99
    v_fma_f32 v100, v100, s42, -v7
    v_fma_f32 v101, v101, s42, -v7
    v_fma_f32 v102, v102, s42, -v7
    v_fma_f32 v103, v103, s42, -v7
    v_exp_f32 v100, v100
    v_exp_f32 v101, v101
    v_exp_f32 v102, v102
    v_exp_f32 v103, v103
    s_nop 0
    v_add_f32 v9, v9, v100
    v_add_f32 v9, v9, v101
    v_add_f32 v9, v9, v102
    v_add_f32 v9, v9, v103
    v_cvt_pk_bf16_f32 v33, v88, v88
    v_cvt_pk_bf16_f32 v35, v89, v89
    v_cvt_pk_bf16_f32 v37, v90, v90
    v_cvt_pk_bf16_f32 v39, v91, v91
    v_and_b32 v32, v4, v33
    v_and_b32 v33, v5, v33
    v_and_b32 v34, v4, v35
    v_and_b32 v35, v5, v35
    v_and_b32 v36, v4, v37
    v_and_b32 v37, v5, v37
    v_and_b32 v38, v4, v39
    v_and_b32 v39, v5, v39
    s_nop 0
    s_waitcnt vmcnt(5)
    v_mfma_f32_16x16x16_bf16 v[24:27], v[32:33], v[152:153], v[24:27]
    v_mfma_f32_16x16x16_bf16 v[28:31], v[32:33], v[154:155], v[28:31]
    buffer_load_dwordx4 v[176:179], v1, s[20:23], s44 offen offset:2048 nt
    s_waitcnt vmcnt(5)
    v_mfma_f32_16x16x16_bf16 v[24:27], v[34:35], v[156:157], v[24:27]
    v_mfma_f32_16x16x16_bf16 v[28:31], v[34:35], v[158:159], v[28:31]
    buffer_load_dwordx4 v[180:183], v1, s[20:23], s44 offen offset:3072 nt
    s_waitcnt vmcnt(5)
    v_mfma_f32_16x16x16_bf16 v[24:27], v[36:37], v[160:161], v[24:27]
    v_mfma_f32_16x16x16_bf16 v[28:31], v[36:37], v[162:163], v[28:31]
    s_add_u32 s44, s44, 16384
    buffer_load_dwordx4 v[136:139], v1, s[20:23], s44 offen offset:0 nt
    s_waitcnt vmcnt(5)
    v_mfma_f32_16x16x16_bf16 v[24:27], v[38:39], v[164:165], v[24:27]
    v_mfma_f32_16x16x16_bf16 v[28:31], v[38:39], v[166:167], v[28:31]
    buffer_load_dwordx4 v[140:143], v1, s[20:23], s44 offen offset:1024 nt
    v_fma_f32 v104, v104, s42, -v7
    v_fma_f32 v105, v105, s42, -v7
    v_fma_f32 v106, v106, s42, -v7
    v_fma_f32 v107, v107, s42, -v7
    v_exp_f32 v104, v104
    v_exp_f32 v105, v105
    v_exp_f32 v106, v106
    v_exp_f32 v107, v107
    s_nop 0
    v_add_f32 v9, v9, v104
    v_add_f32 v9, v9, v105
    v_add_f32 v9, v9, v106
    v_add_f32 v9, v9, v107
    v_fma_f32 v108, v108, s42, -v7
    v_fma_f32 v109, v109, s42, -v7
    v_fma_f32 v110, v110, s42, -v7
    v_fma_f32 v111, v111, s42, -v7
    v_exp_f32 v108, v108
    v_exp_f32 v109, v109
    v_exp_f32 v110, v110
    v_exp_f32 v111, v111
    s_nop 0
    v_add_f32 v9, v9, v108
    v_add_f32 v9, v9, v109
    v_add_f32 v9, v9, v110
    v_add_f32 v9, v9, v111
    v_cvt_pk_bf16_f32 v33, v92, v92
    v_cvt_pk_bf16_f32 v35, v93, v93
    v_cvt_pk_bf16_f32 v37, v94, v94
    v_cvt_pk_bf16_f32 v39, v95, v95
    v_and_b32 v32, v4, v33
    v_and_b32 v33, v5, v33
    v_and_b32 v34, v4, v35
    v_and_b32 v35, v5, v35
    v_and_b32 v36, v4, v37
    v_and_b32 v37, v5, v37
    v_and_b32 v38, v4, v39
    v_and_b32 v39, v5, v39
    s_nop 0
    s_waitcnt vmcnt(5)
    v_mfma_f32_16x16x16_bf16 v[24:27], v[32:33], v[168:169], v[24:27]
    v_mfma_f32_16x16x16_bf16 v[28:31], v[32:33], v[170:171], v[28:31]
    buffer_load_dwordx4 v[144:147], v1, s[20:23], s44 offen offset:2048 nt
    s_waitcnt vmcnt(5)
    v_mfma_f32_16x16x16_bf16 v[24:27], v[34:35], v[172:173], v[24:27]
    v_mfma_f32_16x16x16_bf16 v[28:31], v[34:35], v[174:175], v[28:31]
    buffer_load_dwordx4 v[148:151], v1, s[20:23], s44 offen offset:3072 nt
    s_waitcnt vmcnt(5)
    v_mfma_f32_16x16x16_bf16 v[24:27], v[36:37], v[176:177], v[24:27]
    v_mfma_f32_16x16x16_bf16 v[28:31], v[36:37], v[178:179], v[28:31]
    s_add_u32 s44, s44, 16384
    buffer_load_dwordx4 v[152:155], v1, s[20:23], s44 offen offset:0 nt
    s_waitcnt vmcnt(5)
    v_mfma_f32_16x16x16_bf16 v[24:27], v[38:39], v[180:181], v[24:27]
    v_mfma_f32_16x16x16_bf16 v[28:31], v[38:39], v[182:183], v[28:31]
    buffer_load_dwordx4 v[156:159], v1, s[20:23], s44 offen offset:1024 nt
    v_fma_f32 v112, v112, s42, -v7
    v_fma_f32 v113, v113, s42, -v7
    v_fma_f32 v114, v114, s42, -v7
    v_fma_f32 v115, v115, s42, -v7
    v_exp_f32 v112, v112
    v_exp_f32 v113, v113
    v_exp_f32 v114, v114
    v_exp_f32 v115, v115
    s_nop 0
    v_add_f32 v9, v9, v112
    v_add_f32 v9, v9, v113
    v_add_f32 v9, v9, v114
    v_add_f32 v9, v9, v115
    v_cvt_pk_bf16_f32 v33, v96, v96
    v_cvt_pk_bf16_f32 v35, v97, v97
    v_cvt_pk_bf16_f32 v37, v98, v98
    v_cvt_pk_bf16_f32 v39, v99, v99
    v_and_b32 v32, v4, v33
    v_and_b32 v33, v5, v33
    v_and_b32 v34, v4, v35
    v_and_b32 v35, v5, v35
    v_and_b32 v36, v4, v37
    v_and_b32 v37, v5, v37
    v_and_b32 v38, v4, v39
    v_and_b32 v39, v5, v39
    s_nop 0
    s_waitcnt vmcnt(5)
    v_mfma_f32_16x16x16_bf16 v[24:27], v[32:33], v[136:137], v[24:27]
    v_mfma_f32_16x16x16_bf16 v[28:31], v[32:33], v[138:139], v[28:31]
    buffer_load_dwordx4 v[160:163], v1, s[20:23], s44 offen offset:2048 nt
    s_waitcnt vmcnt(5)
    v_mfma_f32_16x16x16_bf16 v[24:27], v[34:35], v[140:141], v[24:27]
    v_mfma_f32_16x16x16_bf16 v[28:31], v[34:35], v[142:143], v[28:31]
    buffer_load_dwordx4 v[164:167], v1, s[20:23], s44 offen offset:3072 nt
    s_waitcnt vmcnt(5)
    v_mfma_f32_16x16x16_bf16 v[24:27], v[36:37], v[144:145], v[24:27]
    v_mfma_f32_16x16x16_bf16 v[28:31], v[36:37], v[146:147], v[28:31]
    s_add_u32 s44, s44, 16384
    buffer_load_dwordx4 v[168:171], v1, s[20:23], s44 offen offset:0 nt
    s_waitcnt vmcnt(5)
    v_mfma_f32_16x16x16_bf16 v[24:27], v[38:39], v[148:149], v[24:27]
    v_mfma_f32_16x16x16_bf16 v[28:31], v[38:39], v[150:151], v[28:31]
    buffer_load_dwordx4 v[172:175], v1, s[20:23], s44 offen offset:1024 nt
    v_fma_f32 v116, v116, s42, -v7
    v_fma_f32 v117, v117, s42, -v7
    v_fma_f32 v118, v118, s42, -v7
    v_fma_f32 v119, v119, s42, -v7
    v_exp_f32 v116, v116
    v_exp_f32 v117, v117
    v_exp_f32 v118, v118
    v_exp_f32 v119, v119
    s_nop 0
    v_add_f32 v9, v9, v116
    v_add_f32 v9, v9, v117
    v_add_f32 v9, v9, v118
    v_add_f32 v9, v9, v119
    v_fma_f32 v120, v120, s42, -v7
    v_fma_f32 v121, v121, s42, -v7
    v_fma_f32 v122, v122, s42, -v7
    v_fma_f32 v123, v123, s42, -v7
    v_exp_f32 v120, v120
    v_exp_f32 v121, v121
    v_exp_f32 v122, v122
    v_exp_f32 v123, v123
    s_nop 0
    v_add_f32 v9, v9, v120
    v_add_f32 v9, v9, v121
    v_add_f32 v9, v9, v122
    v_add_f32 v9, v9, v123
    v_cvt_pk_bf16_f32 v33, v100, v100
    v_cvt_pk_bf16_f32 v35, v101, v101
    v_cvt_pk_bf16_f32 v37, v102, v102
    v_cvt_pk_bf16_f32 v39, v103, v103
    v_and_b32 v32, v4, v33
    v_and_b32 v33, v5, v33
    v_and_b32 v34, v4, v35
    v_and_b32 v35, v5, v35
    v_and_b32 v36, v4, v37
    v_and_b32 v37, v5, v37
    v_and_b32 v38, v4, v39
    v_and_b32 v39, v5, v39
    s_nop 0
    s_waitcnt vmcnt(5)
    v_mfma_f32_16x16x16_bf16 v[24:27], v[32:33], v[152:153], v[24:27]
    v_mfma_f32_16x16x16_bf16 v[28:31], v[32:33], v[154:155], v[28:31]
    buffer_load_dwordx4 v[176:179], v1, s[20:23], s44 offen offset:2048 nt
    s_waitcnt vmcnt(5)
    v_mfma_f32_16x16x16_bf16 v[24:27], v[34:35], v[156:157], v[24:27]
    v_mfma_f32_16x16x16_bf16 v[28:31], v[34:35], v[158:159], v[28:31]
    buffer_load_dwordx4 v[180:183], v1, s[20:23], s44 offen offset:3072 nt
    s_waitcnt vmcnt(5)
    v_mfma_f32_16x16x16_bf16 v[24:27], v[36:37], v[160:161], v[24:27]
    v_mfma_f32_16x16x16_bf16 v[28:31], v[36:37], v[162:163], v[28:31]
    s_add_u32 s44, s44, 16384
    buffer_load_dwordx4 v[136:139], v1, s[20:23], s44 offen offset:0 nt
    s_waitcnt vmcnt(5)
    v_mfma_f32_16x16x16_bf16 v[24:27], v[38:39], v[164:165], v[24:27]
    v_mfma_f32_16x16x16_bf16 v[28:31], v[38:39], v[166:167], v[28:31]
    buffer_load_dwordx4 v[140:143], v1, s[20:23], s44 offen offset:1024 nt
    v_fma_f32 v124, v124, s42, -v7
    v_fma_f32 v125, v125, s42, -v7
    v_fma_f32 v126, v126, s42, -v7
    v_fma_f32 v127, v127, s42, -v7
    v_exp_f32 v124, v124
    v_exp_f32 v125, v125
    v_exp_f32 v126, v126
    v_exp_f32 v127, v127
    s_nop 0
    v_add_f32 v9, v9, v124
    v_add_f32 v9, v9, v125
    v_add_f32 v9, v9, v126
    v_add_f32 v9, v9, v127
    v_fma_f32 v128, v128, s42, -v7
    v_fma_f32 v129, v129, s42, -v7
    v_fma_f32 v130, v130, s42, -v7
    v_fma_f32 v131, v131, s42, -v7
    v_exp_f32 v128, v128
    v_exp_f32 v129, v129
    v_exp_f32 v130, v130
    v_exp_f32 v131, v131
    s_nop 0
    v_add_f32 v9, v9, v128
    v_add_f32 v9, v9, v129
    v_add_f32 v9, v9, v130
    v_add_f32 v9, v9, v131
    v_cvt_pk_bf16_f32 v33, v104, v104
    v_cvt_pk_bf16_f32 v35, v105, v105
    v_cvt_pk_bf16_f32 v37, v106, v106
    v_cvt_pk_bf16_f32 v39, v107, v107
    v_and_b32 v32, v4, v33
    v_and_b32 v33, v5, v33
    v_and_b32 v34, v4, v35
    v_and_b32 v35, v5, v35
    v_and_b32 v36, v4, v37
    v_and_b32 v37, v5, v37
    v_and_b32 v38, v4, v39
    v_and_b32 v39, v5, v39
    s_nop 0
    s_waitcnt vmcnt(5)
    v_mfma_f32_16x16x16_bf16 v[24:27], v[32:33], v[168:169], v[24:27]
    v_mfma_f32_16x16x16_bf16 v[28:31], v[32:33], v[170:171], v[28:31]
    buffer_load_dwordx4 v[144:147], v1, s[20:23], s44 offen offset:2048 nt
    buffer_load_dwordx4 v[148:151], v1, s[20:23], s44 offen offset:3072 nt
    s_waitcnt vmcnt(6)
    v_mfma_f32_16x16x16_bf16 v[24:27], v[34:35], v[172:173], v[24:27]
    v_mfma_f32_16x16x16_bf16 v[28:31], v[34:35], v[174:175], v[28:31]
    s_add_u32 s44, s44, 16384
    buffer_load_dwordx4 v[152:155], v1, s[20:23], s44 offen offset:0 nt
    s_waitcnt vmcnt(6)
    v_mfma_f32_16x16x16_bf16 v[24:27], v[36:37], v[176:177], v[24:27]
    v_mfma_f32_16x16x16_bf16 v[28:31], v[36:37], v[178:179], v[28:31]
    buffer_load_dwordx4 v[156:159], v1, s[20:23], s44 offen offset:1024 nt
    buffer_load_dwordx4 v[160:163], v1, s[20:23], s44 offen offset:2048 nt
    s_waitcnt vmcnt(7)
    v_mfma_f32_16x16x16_bf16 v[24:27], v[38:39], v[180:181], v[24:27]
    v_mfma_f32_16x16x16_bf16 v[28:31], v[38:39], v[182:183], v[28:31]
    buffer_load_dwordx4 v[164:167], v1, s[20:23], s44 offen offset:3072 nt
    v_fma_f32 v132, v132, s42, -v7
    v_fma_f32 v133, v133, s42, -v7
    v_fma_f32 v134, v134, s42, -v7
    v_fma_f32 v135, v135, s42, -v7
    v_exp_f32 v132, v132
    v_exp_f32 v133, v133
    v_exp_f32 v134, v134
    v_exp_f32 v135, v135
    s_nop 0
    v_add_f32 v9, v9, v132
    v_add_f32 v9, v9, v133
    v_add_f32 v9, v9, v134
    v_add_f32 v9, v9, v135
    v_cvt_pk_bf16_f32 v33, v108, v108
    v_cvt_pk_bf16_f32 v35, v109, v109
    v_cvt_pk_bf16_f32 v37, v110, v110
    v_cvt_pk_bf16_f32 v39, v111, v111
    v_and_b32 v32, v4, v33
    v_and_b32 v33, v5, v33
    v_and_b32 v34, v4, v35
    v_and_b32 v35, v5, v35
    v_and_b32 v36, v4, v37
    v_and_b32 v37, v5, v37
    v_and_b32 v38, v4, v39
    v_and_b32 v39, v5, v39
    v_mov_b32 v11, v9
    v_and_b32 v10, 0x30, v0
    v_add_u32 v14, s3, v10
    v_permlane32_swap_b32 v11, v9
    v_add_f32 v9, v9, v11
    v_mov_b32 v11, v9
    v_mov_b32 v3, 0
    v_mov_b32 v15, 1
    v_permlane16_swap_b32 v11, v9
    v_add_f32 v9, v9, v11
    ds_write_b32 v2, v9 offset:8320
    v_add_u32 v11, s45, v1
    s_waitcnt lgkmcnt(0)
    s_barrier
    ds_read_b128 v[56:59], v10 offset:8192
    ds_read_b32 v12, v14 offset:8192
    s_waitcnt vmcnt(7)
    v_mfma_f32_16x16x16_bf16 v[24:27], v[32:33], v[136:137], v[24:27]
    v_mfma_f32_16x16x16_bf16 v[28:31], v[32:33], v[138:139], v[28:31]
    s_add_u32 s44, s44, 16384
    buffer_load_dwordx4 v[168:171], v1, s[20:23], s44 offen offset:0 nt
    buffer_load_dwordx4 v[172:175], v1, s[20:23], s44 offen offset:1024 nt
    s_waitcnt vmcnt(8)
    v_mfma_f32_16x16x16_bf16 v[24:27], v[34:35], v[140:141], v[24:27]
    v_mfma_f32_16x16x16_bf16 v[28:31], v[34:35], v[142:143], v[28:31]
    buffer_load_dwordx4 v[176:179], v1, s[20:23], s44 offen offset:2048 nt
    s_waitcnt vmcnt(8)
    v_mfma_f32_16x16x16_bf16 v[24:27], v[36:37], v[144:145], v[24:27]
    v_mfma_f32_16x16x16_bf16 v[28:31], v[36:37], v[146:147], v[28:31]
    buffer_load_dwordx4 v[180:183], v1, s[20:23], s44 offen offset:3072 nt
    s_add_u32 s44, s44, 16384
    buffer_load_dwordx4 v[136:139], v1, s[20:23], s44 offen offset:0 nt
    s_waitcnt vmcnt(9)
    v_mfma_f32_16x16x16_bf16 v[24:27], v[38:39], v[148:149], v[24:27]
    v_mfma_f32_16x16x16_bf16 v[28:31], v[38:39], v[150:151], v[28:31]
    buffer_load_dwordx4 v[140:143], v1, s[20:23], s44 offen offset:1024 nt
    v_cvt_pk_bf16_f32 v33, v112, v112
    v_cvt_pk_bf16_f32 v35, v113, v113
    v_cvt_pk_bf16_f32 v37, v114, v114
    v_cvt_pk_bf16_f32 v39, v115, v115
    v_and_b32 v32, v4, v33
    v_and_b32 v33, v5, v33
    v_and_b32 v34, v4, v35
    v_and_b32 v35, v5, v35
    v_and_b32 v36, v4, v37
    v_and_b32 v37, v5, v37
    v_and_b32 v38, v4, v39
    v_and_b32 v39, v5, v39
    s_waitcnt lgkmcnt(0)
    v_max3_f32 v10, v56, v57, v58
    v_max_f32 v10, v10, v59
    v_sub_f32 v12, v12, v10
    v_exp_f32 v12, v12
    s_waitcnt vmcnt(9)
    v_mfma_f32_16x16x16_bf16 v[24:27], v[32:33], v[152:153], v[24:27]
    v_mfma_f32_16x16x16_bf16 v[28:31], v[32:33], v[154:155], v[28:31]
    buffer_load_dwordx4 v[144:147], v1, s[20:23], s44 offen offset:2048 nt
    buffer_load_dwordx4 v[148:151], v1, s[20:23], s44 offen offset:3072 nt
    s_waitcnt vmcnt(10)
    v_mfma_f32_16x16x16_bf16 v[24:27], v[34:35], v[156:157], v[24:27]
    v_mfma_f32_16x16x16_bf16 v[28:31], v[34:35], v[158:159], v[28:31]
    s_add_u32 s44, s44, 16384
    buffer_load_dwordx4 v[152:155], v1, s[20:23], s44 offen offset:0 nt
    s_waitcnt vmcnt(10)
    v_mfma_f32_16x16x16_bf16 v[24:27], v[36:37], v[160:161], v[24:27]
    v_mfma_f32_16x16x16_bf16 v[28:31], v[36:37], v[162:163], v[28:31]
    buffer_load_dwordx4 v[156:159], v1, s[20:23], s44 offen offset:1024 nt
    buffer_load_dwordx4 v[160:163], v1, s[20:23], s44 offen offset:2048 nt
    s_waitcnt vmcnt(11)
    v_mfma_f32_16x16x16_bf16 v[24:27], v[38:39], v[164:165], v[24:27]
    v_mfma_f32_16x16x16_bf16 v[28:31], v[38:39], v[166:167], v[28:31]
    buffer_load_dwordx4 v[164:167], v1, s[20:23], s44 offen offset:3072 nt
    v_cvt_pk_bf16_f32 v33, v116, v116
    v_cvt_pk_bf16_f32 v35, v117, v117
    v_cvt_pk_bf16_f32 v37, v118, v118
    v_cvt_pk_bf16_f32 v39, v119, v119
    v_and_b32 v32, v4, v33
    v_and_b32 v33, v5, v33
    v_and_b32 v34, v4, v35
    v_and_b32 v35, v5, v35
    v_and_b32 v36, v4, v37
    v_and_b32 v37, v5, v37
    v_and_b32 v38, v4, v39
    v_and_b32 v39, v5, v39
    s_nop 0
    s_waitcnt vmcnt(11)
    v_mfma_f32_16x16x16_bf16 v[24:27], v[32:33], v[168:169], v[24:27]
    v_mfma_f32_16x16x16_bf16 v[28:31], v[32:33], v[170:171], v[28:31]
    s_add_u32 s44, s44, 16384
    buffer_load_dwordx4 v[168:171], v1, s[20:23], s44 offen offset:0 nt
    v_cvt_pk_bf16_f32 v41, v120, v120
    v_cvt_pk_bf16_f32 v43, v121, v121
    v_cvt_pk_bf16_f32 v45, v122, v122
    v_cvt_pk_bf16_f32 v47, v123, v123
    v_and_b32 v40, v4, v41
    v_and_b32 v41, v5, v41
    v_and_b32 v42, v4, v43
    v_and_b32 v43, v5, v43
    v_and_b32 v44, v4, v45
    v_and_b32 v45, v5, v45
    v_and_b32 v46, v4, v47
    v_and_b32 v47, v5, v47
    v_cvt_pk_bf16_f32 v57, v128, v128
    v_cvt_pk_bf16_f32 v59, v129, v129
    v_cvt_pk_bf16_f32 v61, v130, v130
    v_cvt_pk_bf16_f32 v63, v131, v131
    v_and_b32 v56, v4, v57
    v_and_b32 v57, v5, v57
    v_and_b32 v58, v4, v59
    v_and_b32 v59, v5, v59
    v_and_b32 v60, v4, v61
    v_and_b32 v61, v5, v61
    v_and_b32 v62, v4, v63
    v_and_b32 v63, v5, v63
    s_waitcnt vmcnt(11)
    v_mfma_f32_16x16x16_bf16 v[24:27], v[34:35], v[172:173], v[24:27]
    v_mfma_f32_16x16x16_bf16 v[28:31], v[34:35], v[174:175], v[28:31]
    buffer_load_dwordx4 v[172:175], v1, s[20:23], s44 offen offset:1024 nt
    v_cvt_pk_bf16_f32 v49, v124, v124
    v_cvt_pk_bf16_f32 v51, v125, v125
    v_cvt_pk_bf16_f32 v53, v126, v126
    v_cvt_pk_bf16_f32 v55, v127, v127
    v_and_b32 v48, v4, v49
    v_and_b32 v49, v5, v49
    v_and_b32 v50, v4, v51
    v_and_b32 v51, v5, v51
    v_and_b32 v52, v4, v53
    v_and_b32 v53, v5, v53
    v_and_b32 v54, v4, v55
    v_and_b32 v55, v5, v55
    v_cvt_pk_bf16_f32 v65, v132, v132
    v_cvt_pk_bf16_f32 v67, v133, v133
    v_cvt_pk_bf16_f32 v69, v134, v134
    v_cvt_pk_bf16_f32 v71, v135, v135
    v_and_b32 v64, v4, v65
    v_and_b32 v65, v5, v65
    v_and_b32 v66, v4, v67
    v_and_b32 v67, v5, v67
    v_and_b32 v68, v4, v69
    v_and_b32 v69, v5, v69
    v_and_b32 v70, v4, v71
    v_and_b32 v71, v5, v71
    s_waitcnt vmcnt(11)
    v_mfma_f32_16x16x16_bf16 v[24:27], v[36:37], v[176:177], v[24:27]
    v_mfma_f32_16x16x16_bf16 v[28:31], v[36:37], v[178:179], v[28:31]
    buffer_load_dwordx4 v[176:179], v1, s[20:23], s44 offen offset:2048 nt
    s_waitcnt vmcnt(11)
    v_mfma_f32_16x16x16_bf16 v[24:27], v[38:39], v[180:181], v[24:27]
    v_mfma_f32_16x16x16_bf16 v[28:31], v[38:39], v[182:183], v[28:31]
    buffer_load_dwordx4 v[180:183], v1, s[20:23], s44 offen offset:3072 nt
    s_waitcnt vmcnt(11)
    v_mfma_f32_16x16x16_bf16 v[24:27], v[40:41], v[136:137], v[24:27]
    v_mfma_f32_16x16x16_bf16 v[28:31], v[40:41], v[138:139], v[28:31]
    s_add_u32 s44, s44, 16384
    buffer_load_dwordx4 v[136:139], v1, s[20:23], s44 offen offset:0 nt
    s_waitcnt vmcnt(11)
    v_mfma_f32_16x16x16_bf16 v[24:27], v[42:43], v[140:141], v[24:27]
    v_mfma_f32_16x16x16_bf16 v[28:31], v[42:43], v[142:143], v[28:31]
    buffer_load_dwordx4 v[140:143], v1, s[20:23], s44 offen offset:1024 nt
    s_waitcnt vmcnt(11)
    v_mfma_f32_16x16x16_bf16 v[24:27], v[44:45], v[144:145], v[24:27]
    v_mfma_f32_16x16x16_bf16 v[28:31], v[44:45], v[146:147], v[28:31]
    buffer_load_dwordx4 v[144:147], v1, s[20:23], s44 offen offset:2048 nt
    s_waitcnt vmcnt(11)
    v_mfma_f32_16x16x16_bf16 v[24:27], v[46:47], v[148:149], v[24:27]
    v_mfma_f32_16x16x16_bf16 v[28:31], v[46:47], v[150:151], v[28:31]
    buffer_load_dwordx4 v[148:151], v1, s[20:23], s44 offen offset:3072 nt
    s_waitcnt vmcnt(11)
    v_mfma_f32_16x16x16_bf16 v[24:27], v[48:49], v[152:153], v[24:27]
    v_mfma_f32_16x16x16_bf16 v[28:31], v[48:49], v[154:155], v[28:31]
    s_waitcnt vmcnt(10)
    v_mfma_f32_16x16x16_bf16 v[24:27], v[50:51], v[156:157], v[24:27]
    v_mfma_f32_16x16x16_bf16 v[28:31], v[50:51], v[158:159], v[28:31]
    s_waitcnt vmcnt(9)
    v_mfma_f32_16x16x16_bf16 v[24:27], v[52:53], v[160:161], v[24:27]
    v_mfma_f32_16x16x16_bf16 v[28:31], v[52:53], v[162:163], v[28:31]
    s_waitcnt vmcnt(8)
    v_mfma_f32_16x16x16_bf16 v[24:27], v[54:55], v[164:165], v[24:27]
    v_mfma_f32_16x16x16_bf16 v[28:31], v[54:55], v[166:167], v[28:31]
    s_waitcnt vmcnt(7)
    v_mfma_f32_16x16x16_bf16 v[24:27], v[56:57], v[168:169], v[24:27]
    v_mfma_f32_16x16x16_bf16 v[28:31], v[56:57], v[170:171], v[28:31]
    s_waitcnt vmcnt(6)
    v_mfma_f32_16x16x16_bf16 v[24:27], v[58:59], v[172:173], v[24:27]
    v_mfma_f32_16x16x16_bf16 v[28:31], v[58:59], v[174:175], v[28:31]
    s_waitcnt vmcnt(5)
    v_mfma_f32_16x16x16_bf16 v[24:27], v[60:61], v[176:177], v[24:27]
    v_mfma_f32_16x16x16_bf16 v[28:31], v[60:61], v[178:179], v[28:31]
    s_waitcnt vmcnt(4)
    v_mfma_f32_16x16x16_bf16 v[24:27], v[62:63], v[180:181], v[24:27]
    v_mfma_f32_16x16x16_bf16 v[28:31], v[62:63], v[182:183], v[28:31]
    s_waitcnt vmcnt(3)
    v_mfma_f32_16x16x16_bf16 v[24:27], v[64:65], v[136:137], v[24:27]
    v_mfma_f32_16x16x16_bf16 v[28:31], v[64:65], v[138:139], v[28:31]
    s_waitcnt vmcnt(2)
    v_mfma_f32_16x16x16_bf16 v[24:27], v[66:67], v[140:141], v[24:27]
    v_mfma_f32_16x16x16_bf16 v[28:31], v[66:67], v[142:143], v[28:31]
    s_waitcnt vmcnt(1)
    v_mfma_f32_16x16x16_bf16 v[24:27], v[68:69], v[144:145], v[24:27]
    v_mfma_f32_16x16x16_bf16 v[28:31], v[68:69], v[146:147], v[28:31]
    s_waitcnt vmcnt(0)
    v_mfma_f32_16x16x16_bf16 v[24:27], v[70:71], v[148:149], v[24:27]
    v_mfma_f32_16x16x16_bf16 v[28:31], v[70:71], v[150:151], v[28:31]
    s_nop 6
    v_pk_mul_f32 v[24:25], v[24:25], v[12:13] op_sel:[0,0] op_sel_hi:[1,0]
    v_pk_mul_f32 v[26:27], v[26:27], v[12:13] op_sel:[0,0] op_sel_hi:[1,0]
    v_pk_mul_f32 v[28:29], v[28:29], v[12:13] op_sel:[0,0] op_sel_hi:[1,0]
    v_pk_mul_f32 v[30:31], v[30:31], v[12:13] op_sel:[0,0] op_sel_hi:[1,0]
    ds_write_b128 v11, v[24:27] offset:0
    ds_write_b128 v11, v[28:31] offset:1024
    s_mov_b64 exec, 1
    ds_add_u32 v3, v15 offset:8448
    s_waitcnt lgkmcnt(0)
    s_barrier
    s_endpgm
L_manager:
    s_load_dwordx2 s[36:37], s[0:1], 32
    s_load_dwordx2 s[28:29], s[0:1], 40
    s_load_dwordx2 s[32:33], s[0:1], 24
    s_mov_b32 s30, 0x10000000
    s_mov_b32 s31, 0x20000
    s_mov_b32 s34, 0x10000
    s_mov_b32 s35, 0x20000
    s_mov_b32 s38, 256
    s_mov_b32 s39, 0x20000
    s_lshl_b32 s46, s41, 12
    s_xor_b32 s47, s46, 0x1000
    s_xor_b32 s48, s46, 0x2000
    s_xor_b32 s49, s46, 0x3000
    s_and_b32 s50, s41, 0xfc
    s_lshl_b32 s3, s50, 8
    s_getreg_b32 s51, hwreg(HW_REG_XCC_ID, 0, 4)
    s_mul_i32 s4, s51, s51
    s_lshl_b32 s4, s4, 8
    s_or_b32 s51, s51, s4
    s_lshl_b32 s51, s51, 8
    s_or_b32 s52, s51, 1
    v_lshrrev_b32 v2, 1, v1
    v_mov_b32 v3, 0
    v_mov_b32 v12, 0
    v_mov_b32 v13, 0
    v_and_b32 v7, 0x30, v0
    ds_write_b32 v3, v3 offset:8448
    v_mov_b32 v16, -1
    v_mov_b32 v17, -1
    v_mov_b32 v18, -1
    v_mov_b32 v19, -1
    s_mov_b32 s55, 0x40000
    s_mov_b32 s53, 0
    s_mov_b32 s5, 0xfffffffe
    s_waitcnt lgkmcnt(0)
    buffer_store_dwordx4 v[16:19], v1, s[28:31], s46 offen
    buffer_store_dwordx4 v[16:19], v1, s[28:31], s46 offen offset:1024
    buffer_store_dwordx2 v[16:17], v2, s[28:31], s46 offen offset:2048
    s_mov_b64 exec, 0xffff
    buffer_store_dwordx2 v[12:13], v2, s[28:31], s46 offen offset:2560
    s_mov_b64 exec, -1
    s_waitcnt vmcnt(0)
    s_barrier
    s_atomic_add s52, s[36:37], s50 glc
    ds_read_b128 v[96:99], v7 offset:8192
    ds_read_b128 v[100:103], v7 offset:8320
    s_waitcnt lgkmcnt(0)
    v_max3_f32 v4, v96, v97, v98
    v_max_f32 v4, v4, v99
    v_sub_f32 v96, v96, v4
    v_sub_f32 v97, v97, v4
    v_sub_f32 v98, v98, v4
    v_sub_f32 v99, v99, v4
    v_exp_f32 v96, v96
    v_exp_f32 v97, v97
    v_exp_f32 v98, v98
    v_exp_f32 v99, v99
    v_mul_f32 v5, v96, v100
    v_fma_f32 v5, v97, v101, v5
    v_fma_f32 v5, v98, v102, v5
    v_fma_f32 v5, v99, v103, v5
    v_min_u32 v4, s5, v4
    v_min_u32 v5, s5, v5
    s_and_b32 s4, s52, 15
    s_cmp_eq_u32 s4, 3
    s_cbranch_scc1 C_last
    buffer_store_dwordx2 v[4:5], v2, s[28:31], s46 offen offset:2048
P_box:
    s_sub_u32 s55, s55, 1
    s_cbranch_scc1 L_end
    s_mov_b64 exec, 1
    buffer_load_dword v6, off, s[28:31], s46 offset:2560 sc1
    s_mov_b64 exec, -1
    s_waitcnt vmcnt(0)
    ds_read_b32 v7, v3 offset:8448
    v_readfirstlane_b32 s4, v6
    s_cmp_eq_u32 s4, 1
    s_cbranch_scc1 P_near
    s_waitcnt lgkmcnt(0)
    v_readfirstlane_b32 s4, v7
    s_cmp_lg_u32 s4, 4
    s_cbranch_scc1 P_box
    s_barrier
    ds_read_b128 v[16:19], v1 offset:0
    ds_read_b128 v[20:23], v1 offset:1024
    ds_read_b128 v[24:27], v1 offset:2048
    ds_read_b128 v[28:31], v1 offset:3072
    ds_read_b128 v[32:35], v1 offset:4096
    ds_read_b128 v[36:39], v1 offset:5120
    ds_read_b128 v[40:43], v1 offset:6144
    ds_read_b128 v[44:47], v1 offset:7168
    s_waitcnt lgkmcnt(4)
    v_pk_add_f32 v[16:17], v[16:17], v[24:25]
    v_pk_add_f32 v[18:19], v[18:19], v[26:27]
    v_pk_add_f32 v[20:21], v[20:21], v[28:29]
    v_pk_add_f32 v[22:23], v[22:23], v[30:31]
    s_waitcnt lgkmcnt(2)
    v_pk_add_f32 v[16:17], v[16:17], v[32:33]
    v_pk_add_f32 v[18:19], v[18:19], v[34:35]
    v_pk_add_f32 v[20:21], v[20:21], v[36:37]
    v_pk_add_f32 v[22:23], v[22:23], v[38:39]
    s_waitcnt lgkmcnt(0)
    v_pk_add_f32 v[16:17], v[16:17], v[40:41]
    v_pk_add_f32 v[18:19], v[18:19], v[42:43]
    v_pk_add_f32 v[20:21], v[20:21], v[44:45]
    v_pk_add_f32 v[22:23], v[22:23], v[46:47]
    v_min_u32 v16, s5, v16
    v_min_u32 v17, s5, v17
    v_min_u32 v18, s5, v18
    v_min_u32 v19, s5, v19
    v_min_u32 v20, s5, v20
    v_min_u32 v21, s5, v21
    v_min_u32 v22, s5, v22
    v_min_u32 v23, s5, v23
    buffer_store_dwordx4 v[16:19], v1, s[28:31], s46 offen sc1
    buffer_store_dwordx4 v[20:23], v1, s[28:31], s46 offen offset:1024 sc1
    buffer_store_dwordx2 v[4:5], v2, s[28:31], s46 offen offset:2048 sc1
    s_mov_b32 s4, 0x10000000
    s_waitcnt vmcnt(0)
    s_atomic_add s4, s[36:37], s50 glc
    s_waitcnt lgkmcnt(0)
    s_endpgm
P_near:
    s_waitcnt lgkmcnt(0)
    s_barrier
    ds_read_b128 v[16:19], v1 offset:0
    ds_read_b128 v[20:23], v1 offset:1024
    ds_read_b128 v[24:27], v1 offset:2048
    ds_read_b128 v[28:31], v1 offset:3072
    ds_read_b128 v[32:35], v1 offset:4096
    ds_read_b128 v[36:39], v1 offset:5120
    ds_read_b128 v[40:43], v1 offset:6144
    ds_read_b128 v[44:47], v1 offset:7168
    s_waitcnt lgkmcnt(4)
    v_pk_add_f32 v[16:17], v[16:17], v[24:25]
    v_pk_add_f32 v[18:19], v[18:19], v[26:27]
    v_pk_add_f32 v[20:21], v[20:21], v[28:29]
    v_pk_add_f32 v[22:23], v[22:23], v[30:31]
    s_waitcnt lgkmcnt(2)
    v_pk_add_f32 v[16:17], v[16:17], v[32:33]
    v_pk_add_f32 v[18:19], v[18:19], v[34:35]
    v_pk_add_f32 v[20:21], v[20:21], v[36:37]
    v_pk_add_f32 v[22:23], v[22:23], v[38:39]
    s_waitcnt lgkmcnt(0)
    v_pk_add_f32 v[16:17], v[16:17], v[40:41]
    v_pk_add_f32 v[18:19], v[18:19], v[42:43]
    v_pk_add_f32 v[20:21], v[20:21], v[44:45]
    v_pk_add_f32 v[22:23], v[22:23], v[46:47]
    v_min_u32 v16, s5, v16
    v_min_u32 v17, s5, v17
    v_min_u32 v18, s5, v18
    v_min_u32 v19, s5, v19
    v_min_u32 v20, s5, v20
    v_min_u32 v21, s5, v21
    v_min_u32 v22, s5, v22
    v_min_u32 v23, s5, v23
    buffer_store_dwordx4 v[16:19], v1, s[28:31], s46 offen
    buffer_store_dwordx4 v[20:23], v1, s[28:31], s46 offen offset:1024
    s_endpgm
C_last:
    s_and_b32 s4, s52, 0x0fffff00
    s_mul_i32 s6, s51, 3
    s_cmp_eq_u32 s4, s6
    s_cbranch_scc0 C_far
    v_lshlrev_b32 v7, 8, v1
    v_xor_b32 v7, s46, v7
    v_mov_b32 v6, 1
    s_mov_b64 exec, 0xe
    buffer_store_dword v6, v7, s[28:31], 0 offen offset:2560
    s_mov_b64 exec, -1
    s_branch C_start
C_far:
    ds_read_b32 v7, v3 offset:8448
    s_waitcnt lgkmcnt(0)
    v_readfirstlane_b32 s4, v7
    s_cmp_lg_u32 s4, 4
    s_cbranch_scc1 C_far
C_pub:
    s_sub_u32 s55, s55, 1
    s_cbranch_scc1 L_end
    buffer_load_dword v6, off, s[36:39], s50 sc1
    s_waitcnt vmcnt(0)
    v_readfirstlane_b32 s4, v6
    s_lshr_b32 s4, s4, 28
    s_cmp_lg_u32 s4, 3
    s_cbranch_scc1 C_pub
C_start:
    s_sub_u32 s55, s55, 1
    s_cbranch_scc1 L_end
    buffer_load_dwordx2 v[72:73], v2, s[28:31], s47 offen offset:2048 sc1
    buffer_load_dwordx2 v[74:75], v2, s[28:31], s48 offen offset:2048 sc1
    buffer_load_dwordx2 v[76:77], v2, s[28:31], s49 offen offset:2048 sc1
    buffer_load_dwordx4 v[48:51], v1, s[28:31], s47 offen sc1
    buffer_load_dwordx4 v[52:55], v1, s[28:31], s47 offen offset:1024 sc1
    buffer_load_dwordx4 v[56:59], v1, s[28:31], s48 offen sc1
    buffer_load_dwordx4 v[60:63], v1, s[28:31], s48 offen offset:1024 sc1
    buffer_load_dwordx4 v[64:67], v1, s[28:31], s49 offen sc1
    buffer_load_dwordx4 v[68:71], v1, s[28:31], s49 offen offset:1024 sc1
    s_waitcnt vmcnt(6)
    v_max3_u32 v6, v72, v73, v74
    v_max3_u32 v6, v6, v75, v76
    v_max_u32 v6, v6, v77
    v_cmp_eq_u32 vcc, -1, v6
    s_cbranch_vccnz C_start
    v_max3_f32 v6, v4, v72, v74
    v_max_f32 v6, v6, v76
    v_sub_f32 v8, v4, v6
    v_sub_f32 v9, v72, v6
    v_sub_f32 v10, v74, v6
    v_sub_f32 v11, v76, v6
    v_exp_f32 v8, v8
    v_exp_f32 v9, v9
    v_exp_f32 v10, v10
    v_exp_f32 v11, v11
    s_nop 0
    v_mul_f32 v5, v8, v5
    v_mul_f32 v73, v9, v73
    v_mul_f32 v75, v10, v75
    v_mul_f32 v77, v11, v77
    v_add_f32 v5, v5, v73
    v_add_f32 v75, v75, v77
    v_add_f32 v5, v5, v75
    v_rcp_f32 v6, v5
    s_nop 0
    v_mul_f32 v8, v6, v8
    v_mul_f32 v9, v6, v9
    v_mul_f32 v10, v6, v10
    v_mul_f32 v11, v6, v11
C_loop:
    s_sub_u32 s55, s55, 1
    s_cbranch_scc1 L_end
    s_cmp_lg_u32 s53, 0
    s_cbranch_scc1 C_wait
    ds_read_b32 v7, v3 offset:8448
    s_mov_b32 s54, 0
    s_waitcnt lgkmcnt(0)
    v_readfirstlane_b32 s6, v7
    s_cmp_eq_u32 s6, 4
    s_cbranch_scc1 C_red
C_wait:
    s_waitcnt vmcnt(0)
    v_max3_u32 v6, v48, v49, v50
    v_max3_u32 v7, v51, v52, v53
    v_max3_u32 v6, v6, v54, v55
    v_max3_u32 v7, v7, v56, v57
    v_max3_u32 v6, v6, v58, v59
    v_max3_u32 v7, v7, v60, v61
    v_max3_u32 v6, v6, v62, v63
    v_max3_u32 v7, v7, v64, v65
    v_max3_u32 v6, v6, v66, v67
    v_max3_u32 v7, v7, v68, v69
    v_max3_u32 v6, v6, v70, v71
    v_max_u32 v6, v6, v7
    v_cmp_eq_u32 vcc, -1, v6
    s_cbranch_vccz C_ok
    buffer_load_dwordx4 v[48:51], v1, s[28:31], s47 offen sc1
    buffer_load_dwordx4 v[52:55], v1, s[28:31], s47 offen offset:1024 sc1
    buffer_load_dwordx4 v[56:59], v1, s[28:31], s48 offen sc1
    buffer_load_dwordx4 v[60:63], v1, s[28:31], s48 offen offset:1024 sc1
    buffer_load_dwordx4 v[64:67], v1, s[28:31], s49 offen sc1
    buffer_load_dwordx4 v[68:71], v1, s[28:31], s49 offen offset:1024 sc1
    s_branch C_loop
C_ok:
    v_pk_mul_f32 v[56:57], v[56:57], v[10:11] op_sel:[0,0] op_sel_hi:[1,0]
    v_pk_mul_f32 v[58:59], v[58:59], v[10:11] op_sel:[0,0] op_sel_hi:[1,0]
    v_pk_mul_f32 v[60:61], v[60:61], v[10:11] op_sel:[0,0] op_sel_hi:[1,0]
    v_pk_mul_f32 v[62:63], v[62:63], v[10:11] op_sel:[0,0] op_sel_hi:[1,0]
    v_pk_mul_f32 v[64:65], v[64:65], v[10:11] op_sel:[0,1] op_sel_hi:[1,1]
    v_pk_mul_f32 v[66:67], v[66:67], v[10:11] op_sel:[0,1] op_sel_hi:[1,1]
    v_pk_mul_f32 v[68:69], v[68:69], v[10:11] op_sel:[0,1] op_sel_hi:[1,1]
    v_pk_mul_f32 v[70:71], v[70:71], v[10:11] op_sel:[0,1] op_sel_hi:[1,1]
    v_pk_mul_f32 v[80:81], v[48:49], v[8:9] op_sel:[0,1] op_sel_hi:[1,1]
    v_pk_mul_f32 v[82:83], v[50:51], v[8:9] op_sel:[0,1] op_sel_hi:[1,1]
    v_pk_mul_f32 v[84:85], v[52:53], v[8:9] op_sel:[0,1] op_sel_hi:[1,1]
    v_pk_mul_f32 v[86:87], v[54:55], v[8:9] op_sel:[0,1] op_sel_hi:[1,1]
    v_pk_add_f32 v[88:89], v[56:57], v[64:65]
    v_pk_add_f32 v[90:91], v[58:59], v[66:67]
    v_pk_add_f32 v[92:93], v[60:61], v[68:69]
    v_pk_add_f32 v[94:95], v[62:63], v[70:71]
    s_cmp_lg_u32 s53, 0
    s_cbranch_scc1 C_out
    s_mov_b32 s54, 1
C_red:
    s_barrier
    ds_read_b128 v[16:19], v1 offset:0
    ds_read_b128 v[20:23], v1 offset:1024
    ds_read_b128 v[24:27], v1 offset:2048
    ds_read_b128 v[28:31], v1 offset:3072
    ds_read_b128 v[32:35], v1 offset:4096
    ds_read_b128 v[36:39], v1 offset:5120
    ds_read_b128 v[40:43], v1 offset:6144
    ds_read_b128 v[44:47], v1 offset:7168
    s_waitcnt lgkmcnt(4)
    v_pk_add_f32 v[16:17], v[16:17], v[24:25]
    v_pk_add_f32 v[18:19], v[18:19], v[26:27]
    v_pk_add_f32 v[20:21], v[20:21], v[28:29]
    v_pk_add_f32 v[22:23], v[22:23], v[30:31]
    s_waitcnt lgkmcnt(2)
    v_pk_add_f32 v[16:17], v[16:17], v[32:33]
    v_pk_add_f32 v[18:19], v[18:19], v[34:35]
    v_pk_add_f32 v[20:21], v[20:21], v[36:37]
    v_pk_add_f32 v[22:23], v[22:23], v[38:39]
    s_waitcnt lgkmcnt(0)
    v_pk_add_f32 v[16:17], v[16:17], v[40:41]
    v_pk_add_f32 v[18:19], v[18:19], v[42:43]
    v_pk_add_f32 v[20:21], v[20:21], v[44:45]
    v_pk_add_f32 v[22:23], v[22:23], v[46:47]
    v_pk_mul_f32 v[16:17], v[16:17], v[8:9] op_sel:[0,0] op_sel_hi:[1,0]
    v_pk_mul_f32 v[18:19], v[18:19], v[8:9] op_sel:[0,0] op_sel_hi:[1,0]
    v_pk_mul_f32 v[20:21], v[20:21], v[8:9] op_sel:[0,0] op_sel_hi:[1,0]
    v_pk_mul_f32 v[22:23], v[22:23], v[8:9] op_sel:[0,0] op_sel_hi:[1,0]
    s_mov_b32 s53, 1
    s_cmp_eq_u32 s54, 0
    s_cbranch_scc1 C_wait
C_out:
    v_pk_add_f32 v[16:17], v[16:17], v[80:81]
    v_pk_add_f32 v[18:19], v[18:19], v[82:83]
    v_pk_add_f32 v[20:21], v[20:21], v[84:85]
    v_pk_add_f32 v[22:23], v[22:23], v[86:87]
    v_pk_add_f32 v[16:17], v[16:17], v[88:89]
    v_pk_add_f32 v[18:19], v[18:19], v[90:91]
    v_pk_add_f32 v[20:21], v[20:21], v[92:93]
    v_pk_add_f32 v[22:23], v[22:23], v[94:95]
    v_cvt_pk_bf16_f32 v24, v16, v17
    v_cvt_pk_bf16_f32 v25, v18, v19
    v_cvt_pk_bf16_f32 v26, v20, v21
    v_cvt_pk_bf16_f32 v27, v22, v23
    buffer_store_dwordx4 v[24:27], v1, s[32:35], s3 offen
L_end:
    s_endpgm
.section .rodata,"a"
.p2align 6
.amdhsa_kernel standalone__gqa_softmax__sampling_kernel
  .amdhsa_next_free_vgpr 184
  .amdhsa_next_free_sgpr 64
  .amdhsa_accum_offset 184
  .amdhsa_group_segment_fixed_size 0
  .amdhsa_kernarg_size 48
  .amdhsa_user_sgpr_count 2
  .amdhsa_user_sgpr_kernarg_segment_ptr 1
  .amdhsa_system_sgpr_workgroup_id_x 1
.end_amdhsa_kernel
```
